```python
import torch

def _softmax(x, axis=-1):
    return torch.softmax(x, dim=axis)
def _gelu(x):
    return torch.nn.functional.gelu(x, approximate="tanh")
def _silu(x):
    return torch.nn.functional.silu(x)
def _sigmoid(x):
    return torch.sigmoid(x)
def _layernorm(x, axis=-1, eps=1e-5):
    m = x.mean(dim=axis, keepdim=True)
    v = x.var(dim=axis, keepdim=True, unbiased=False)
    return (x - m) / torch.sqrt(v + eps)
def _scatter_add(tgt, idx, src, axis=0):
    return tgt.clone().index_add_(axis, idx, src)
def _segment_sum(src, seg, n):
    out = torch.zeros((n,) + src.shape[1:], dtype=src.dtype)
    return out.index_add_(0, seg, src)
def _pad(x, pw):
    flat = tuple(v for pair in reversed(pw) for v in pair)
    return torch.nn.functional.pad(x, flat)

kernel_name = 'standalone__cross_network_dcn__recsys'

def setup_inputs():

    _w = (lambda a: (lambda t: t.to(torch.bfloat16) if t.is_floating_point() else t)(torch.as_tensor(a)))
    B, F, D, L = 4096, 100, 64, 3
    Din = min(F * D, 1024)
    return {
        "x0": _w((lambda *s: torch.randn(*s, dtype=torch.bfloat16) * 0.05)(B, Din)),
        "ws": _w((lambda *s: torch.randn(*s, dtype=torch.bfloat16) * 0.8)(L, Din, Din) * (Din ** -0.5)),
        "bs": _w((lambda *s: torch.randn(*s, dtype=torch.bfloat16) * 3.2)(L, Din) * 0.01),
    }

def reference(x0, ws, bs):
    x = x0
    L = ws.shape[0]
    for l in range(L):
        proj = torch.einsum('bd,de->be', x, ws[l]) + bs[l]
        x = x0 * proj + x
    return x
```

```asm
; @launch grid=(256,1,1) block=(512,1,1) lds=163840
.amdgcn_target "amdgcn-amd-amdhsa--gfx950"
.text
.globl standalone__cross_network_dcn__recsys_kernel
.p2align 8
.type standalone__cross_network_dcn__recsys_kernel,@function
standalone__cross_network_dcn__recsys_kernel:

  s_cmp_ge_u32 s2, 256
  s_cbranch_scc1 L_end
  s_load_dwordx8 s[4:11], s[0:1], 0
  s_load_dwordx4 s[12:15], s[0:1], 32
  v_lshrrev_b32 v1, 6, v0
  v_and_b32 v0, 63, v0
  v_readfirstlane_b32 s3, v1
  s_and_b32 s16, s2, 7
  s_lshr_b32 s17, s2, 3
  s_and_b32 s18, s17, 7
  s_lshr_b32 s17, s17, 3
  s_lshl_b32 s16, s16, 2
  s_add_u32 s16, s16, s17
  s_cmp_lt_u32 s3, 4
  s_cbranch_scc1 L_compute
  s_add_u32 s30, s18, s17
  s_and_b32 s30, s30, 1
  s_lshl_b32 s30, s30, 3
  s_mov_b32 s34, 0
  s_mov_b32 s50, 0
  s_mov_b32 s57, 99
  s_lshl_b32 s54, s17, 2
  s_lshl_b32 s36, s18, 1
  s_cmp_eq_u32 s54, s36
  s_cselect_b32 s36, 2, 0
  s_add_u32 s54, s54, s36
  s_and_b32 s54, s54, 15
  s_cmp_ge_u32 s3, 6
  s_cbranch_scc1 L_xload
  s_sub_u32 s19, s3, 4
  v_lshrrev_b32 v1, 4, v0
  v_and_b32 v2, 15, v0
  v_lshlrev_b32 v3, 1, v1
  v_xor_b32 v3, v2, v3
  v_lshlrev_b32 v3, 4, v3
  v_lshl_add_u32 v4, v1, 11, v3
  v_xor_b32 v3, 128, v4
  v_add_u32 v5, 15360, v3
  v_add_u32 v6, 30720, v4
  v_add_u32 v7, 46080, v3
  v_mov_b32 v8, v4
  v_add_u32 v9, 7168, v3
  v_add_u32 v10, 14336, v4
  v_add_u32 v11, 21504, v3
  s_lshl_b32 s37, s18, 8
  s_mov_b32 s31, 17
  s_lshl_b32 s32, s19, 16
  s_add_u32 s32, s32, s37
  s_mov_b32 s33, 8192
  s_lshl_b32 s35, s19, 13
  s_mov_b32 s41, 0
  s_waitcnt lgkmcnt(0)
  s_mov_b32 s20, s6
  s_mov_b32 s21, s7
  s_mov_b32 s22, 0x600000
  s_mov_b32 s23, 0x20000
  s_branch L_lcommon
L_xload:
  s_sub_u32 s19, s3, 6
  v_lshrrev_b32 v1, 3, v0
  v_and_b32 v2, 7, v0
  v_lshrrev_b32 v3, 1, v1
  v_xor_b32 v2, v2, v3
  v_lshlrev_b32 v2, 4, v2
  v_lshl_add_u32 v4, v1, 11, v2
  v_xor_b32 v3, 64, v4
  v_add_u32 v5, 15360, v3
  v_add_u32 v6, 30720, v4
  v_add_u32 v7, 46080, v3
  v_mov_b32 v8, v4
  v_mov_b32 v9, v5
  v_mov_b32 v10, v6
  v_mov_b32 v11, v7
  s_mov_b32 s31, 7
  s_lshl_b32 s32, s16, 18
  s_lshl_b32 s36, s19, 17
  s_add_u32 s32, s32, s36
  s_mov_b32 s33, 65536
  s_lshl_b32 s35, s19, 13
  s_add_u32 s35, s35, 16384
  s_mov_b32 s41, 1
  s_waitcnt lgkmcnt(0)
  s_mov_b32 s20, s4
  s_mov_b32 s21, s5
  s_mov_b32 s22, 0x800000
  s_mov_b32 s23, 0x20000
L_lcommon:
  s_lshl_b32 s36, s30, s31
  s_add_u32 s36, s36, s32
  s_add_u32 s37, s34, s35
  s_mov_b32 m0, s37
  s_cmp_eq_u32 s41, 0
  s_cbranch_scc0 L_xpro
  s_call_b64 s[44:45], L_issue_p
  s_call_b64 s[44:45], L_issue_p
  s_call_b64 s[44:45], L_issue_p
  s_lshl_b32 s36, s2, 13
  s_add_u32 s36, s36, 0x200000
  v_lshl_add_u32 v1, v0, 7, s36
  s_mov_b32 s24, s14
  s_mov_b32 s25, s15
  s_mov_b32 s26, 16777216
  s_mov_b32 s27, 0x20000
  s_lshl_b32 s58, s18, 1
  s_add_u32 s58, s58, s19
  s_lshl_b32 s59, s18, 2
  s_add_u32 s59, s59, s19
  s_lshl_b32 s59, s59, 2
  s_lshl_b32 s58, s58, 14
  s_lshl_b32 s36, s16, 18
  s_add_u32 s58, s58, s36
  s_lshl_b32 s36, s16, 9
  s_add_u32 s59, s59, s36
  s_add_u32 s59, s59, 16777216
  v_lshlrev_b32 v13, 4, v0
  v_add_u32 v17, 0x1000, v13
  v_add_u32 v18, 0x2000, v13
  v_add_u32 v19, 0x3000, v13
  s_lshl_b32 s36, s17, 1
  s_sub_u32 s36, s18, s36
  s_and_b32 s36, s36, 7
  s_cmp_lt_u32 s36, 4
  s_cselect_b32 s60, 1, 0

  s_lshl_b32 s36, s30, s31
  s_add_u32 s36, s36, s32
  s_add_u32 s37, s34, s35
  s_mov_b32 m0, s37
  s_waitcnt vmcnt(8)
  s_barrier
  s_call_b64 s[44:45], L_issue_p
  s_call_b64 s[44:45], L_issue_p
  s_waitcnt vmcnt(16)
  s_barrier
  s_mov_b32 s43, 6
  s_call_b64 s[44:45], L_run_p8
  s_waitcnt vmcnt(8)
  s_barrier
  s_call_b64 s[44:45], L_issue_p
  s_cmp_eq_u32 s19, 0
  s_cbranch_scc0 1f
  global_load_dword v12, v1, s[6:7]
1:
  s_cmp_eq_u32 s19, 1
  s_cbranch_scc0 1f
  v_add_u32 v1, 0x200000, v1
  global_load_dword v12, v1, s[6:7]
1:
  s_mov_b32 s43, 3
  s_call_b64 s[44:45], L_run_p8
  s_waitcnt vmcnt(8)
  s_barrier
  s_call_b64 s[44:45], L_issue_p
  s_add_u32 s32, s32, 0x200000
  s_mov_b32 s33, 32768
  s_lshl_b32 s30, s18, 1
  s_mov_b32 s57, s30
  v_mov_b32 v4, v8
  v_mov_b32 v5, v9
  v_mov_b32 v6, v10
  v_mov_b32 v7, v11
  s_lshl_b32 s36, s30, s31
  s_add_u32 s36, s36, s32
  s_add_u32 s37, s34, s35
  s_mov_b32 m0, s37
  s_waitcnt vmcnt(8)
  s_barrier
  s_call_b64 s[44:45], L_issue_p
  s_call_b64 s[44:45], L_issue_p
  s_mov_b32 s30, s54
  s_lshl_b32 s36, s30, s31
  s_add_u32 s36, s36, s32
  s_add_u32 s37, s34, s35
  s_mov_b32 m0, s37
  s_waitcnt vmcnt(16)
  s_barrier
  s_call_b64 s[44:45], L_issue_p
  s_call_b64 s[44:45], L_issue_p
  s_waitcnt vmcnt(24)
  s_barrier
  s_waitcnt vmcnt(16)
  s_barrier
  s_call_b64 s[44:45], L_pub1
  s_lshl_b32 s36, s30, s31
  s_add_u32 s36, s36, s32
  s_add_u32 s37, s34, s35
  s_mov_b32 m0, s37
  s_waitcnt vmcnt(8)
  s_barrier
  s_call_b64 s[44:45], L_issue_p
  s_waitcnt vmcnt(8)
  s_barrier
  s_call_b64 s[44:45], L_issue_p
  s_call_b64 s[44:45], L_pub4
  s_mov_b32 s43, 9
  s_call_b64 s[44:45], L_run_p8
  s_waitcnt vmcnt(8)
  s_barrier
  s_call_b64 s[44:45], L_issue_p
  s_add_u32 s32, s32, 0x200000
  s_mov_b32 s33, 32768
  s_lshl_b32 s30, s18, 1
  s_mov_b32 s57, s30
  v_mov_b32 v4, v8
  v_mov_b32 v5, v9
  v_mov_b32 v6, v10
  v_mov_b32 v7, v11
  s_lshl_b32 s36, s30, s31
  s_add_u32 s36, s36, s32
  s_add_u32 s37, s34, s35
  s_mov_b32 m0, s37
  s_waitcnt vmcnt(8)
  s_barrier
  s_call_b64 s[44:45], L_issue_p
  s_call_b64 s[44:45], L_issue_p
  s_mov_b32 s30, s54
  s_lshl_b32 s36, s30, s31
  s_add_u32 s36, s36, s32
  s_add_u32 s37, s34, s35
  s_mov_b32 m0, s37
  s_waitcnt vmcnt(16)
  s_barrier
  s_call_b64 s[44:45], L_issue_p
  s_call_b64 s[44:45], L_issue_p
  s_waitcnt vmcnt(24)
  s_barrier
  s_waitcnt vmcnt(16)
  s_barrier
  s_call_b64 s[44:45], L_pub1
  s_lshl_b32 s36, s30, s31
  s_add_u32 s36, s36, s32
  s_add_u32 s37, s34, s35
  s_mov_b32 m0, s37
  s_waitcnt vmcnt(8)
  s_barrier
  s_call_b64 s[44:45], L_issue_p
  s_waitcnt vmcnt(8)
  s_barrier
  s_call_b64 s[44:45], L_issue_p
  s_call_b64 s[44:45], L_pub4
  s_mov_b32 s43, 10
  s_call_b64 s[44:45], L_run_p8
  s_waitcnt vmcnt(8)
  s_barrier
  s_waitcnt vmcnt(0)
  s_barrier
  s_barrier
  s_branch L_lend
L_xpro:
  s_call_b64 s[44:45], L_issue_p
  s_call_b64 s[44:45], L_issue_p
  s_call_b64 s[44:45], L_issue_p
L_xflow:
  s_lshl_b32 s36, s18, 8
  s_lshl_b32 s37, s19, 7
  s_add_u32 s36, s36, s37
  s_add_u32 s36, s36, 0x800
  v_lshrrev_b32 v16, 4, v0
  v_lshl_add_u32 v16, v16, 3, s36
  s_lshl_b32 s36, s19, 11
  v_lshl_add_u32 v17, v0, 3, s36
  s_lshl_b32 s36, s30, s31
  s_add_u32 s36, s36, s32
  s_add_u32 s37, s34, s35
  s_mov_b32 m0, s37

  s_waitcnt vmcnt(8)
  s_barrier
  s_call_b64 s[44:45], L_issue_p
  s_call_b64 s[44:45], L_issue_p
  global_load_dwordx2 v[24:25], v16, s[8:9] offset:0
  global_load_dwordx2 v[26:27], v16, s[8:9] offset:32
  global_load_dwordx2 v[28:29], v16, s[8:9] offset:64
  global_load_dwordx2 v[30:31], v16, s[8:9] offset:96
  v_add_u32 v16, 0x800, v16
  s_mov_b32 s43, 2
  s_call_b64 s[44:45], L_run_p16
  s_waitcnt vmcnt(16)
  s_barrier
  s_call_b64 s[44:45], L_issue_p
  s_lshl_b32 s36, s16, 3
  v_mov_b32 v13, s36
  global_load_dwordx2 v[14:15], v13, s[12:13] sc1
  s_lshl_b32 s36, s30, s31
  s_add_u32 s36, s36, s32
  s_add_u32 s37, s34, s35
  s_mov_b32 m0, s37
  s_mov_b32 s43, 3
  s_call_b64 s[44:45], L_run_p16
  s_waitcnt vmcnt(16)
  s_barrier
  s_call_b64 s[44:45], L_issue_p
  s_call_b64 s[44:45], L_status
  s_lshl_b32 s36, s30, s31
  s_add_u32 s36, s36, s32
  s_add_u32 s37, s34, s35
  s_mov_b32 m0, s37
  s_mov_b32 s43, 4
  s_call_b64 s[44:45], L_run_p16
  s_waitcnt vmcnt(16)
  s_barrier
  s_waitcnt vmcnt(8)
  s_barrier
  s_waitcnt vmcnt(0)
  s_barrier
  s_mov_b32 s36, s34
  s_add_u32 s36, s36, 32768
  s_cmp_eq_u32 s36, 163840
  s_cselect_b32 s36, 0, s36
  s_add_u32 s36, s36, 32768
  s_cmp_eq_u32 s36, 163840
  s_cselect_b32 s36, 0, s36
  s_add_u32 s36, s36, 16384
  v_add_u32 v18, s36, v17
  s_waitcnt vmcnt(0)
  ds_write_b64 v18, v[24:25] offset:0
  ds_write_b64 v18, v[26:27] offset:512
  ds_write_b64 v18, v[28:29] offset:1024
  ds_write_b64 v18, v[30:31] offset:1536
  s_waitcnt lgkmcnt(0)
  s_mov_b32 s50, s40
  s_mov_b32 s20, s14
  s_mov_b32 s21, s15
  s_mov_b32 s22, 16777216
  s_mov_b32 s23, 0x20000
  v_lshlrev_b32 v4, 4, v0
  v_mov_b32 v5, v4
  v_mov_b32 v6, v4
  v_mov_b32 v7, v4
  s_mov_b32 s31, 14
  s_mov_b32 s33, 4096
  s_lshl_b32 s32, s16, 18
  s_lshl_b32 s36, s19, 13
  s_add_u32 s32, s32, s36
  v_and_b32 v13, 31, v0
  s_lshl_b32 s36, s16, 9
  s_lshl_b32 s37, s50, 7
  s_add_u32 s36, s36, s37
  s_add_u32 s36, s36, 16777216
  v_lshl_add_u32 v13, v13, 2, s36
  s_lshl_b32 s36, s18, 2
  s_lshl_b32 s48, 15, s36
  s_lshl_b32 s36, s17, 3
  s_mov_b32 s51, 65535
  s_lshl_b32 s37, s51, s36
  s_sub_u32 s36, 32, s36
  s_lshr_b32 s51, s51, s36
  s_cmp_eq_u32 s36, 32
  s_cselect_b32 s51, 0, s51
  s_or_b32 s51, s51, s37
  s_not_b32 s51, s51
  s_or_b32 s51, s51, s48
  s_barrier
  s_barrier
  global_load_dwordx2 v[24:25], v16, s[8:9] offset:0
  global_load_dwordx2 v[26:27], v16, s[8:9] offset:32
  global_load_dwordx2 v[28:29], v16, s[8:9] offset:64
  global_load_dwordx2 v[30:31], v16, s[8:9] offset:96
  v_add_u32 v16, 0x800, v16
  s_call_b64 s[44:45], L_xwait
  s_call_b64 s[44:45], L_issue_x
  s_call_b64 s[44:45], L_issue_x

  s_mov_b32 s43, 3
  s_call_b64 s[44:45], L_run_x8
  s_waitcnt vmcnt(8)
  s_barrier
  global_load_dword v14, v13, s[14:15] sc1
  s_call_b64 s[44:45], L_issue_x
  s_waitcnt vmcnt(8)
  s_barrier
  s_call_b64 s[44:45], L_xwait2
  s_call_b64 s[44:45], L_issue_x
  s_mov_b32 s43, 7
  s_call_b64 s[44:45], L_run_x8
  s_waitcnt vmcnt(8)
  s_barrier
  s_waitcnt vmcnt(0)
  s_barrier
  s_mov_b32 s36, s34
  s_add_u32 s36, s36, 32768
  s_cmp_eq_u32 s36, 163840
  s_cselect_b32 s36, 0, s36
  s_add_u32 s36, s36, 32768
  s_cmp_eq_u32 s36, 163840
  s_cselect_b32 s36, 0, s36
  s_add_u32 s36, s36, 16384
  v_add_u32 v18, s36, v17
  s_waitcnt vmcnt(0)
  ds_write_b64 v18, v[24:25] offset:0
  ds_write_b64 v18, v[26:27] offset:512
  ds_write_b64 v18, v[28:29] offset:1024
  ds_write_b64 v18, v[30:31] offset:1536
  s_waitcnt lgkmcnt(0)
  s_barrier
  s_barrier
  s_add_u32 s32, s32, 8388608
  v_add_u32 v13, 256, v13
  s_call_b64 s[44:45], L_xwait
  s_call_b64 s[44:45], L_issue_x
  s_call_b64 s[44:45], L_issue_x

  s_mov_b32 s43, 3
  s_call_b64 s[44:45], L_run_x8
  s_waitcnt vmcnt(8)
  s_barrier
  global_load_dword v14, v13, s[14:15] sc1
  s_call_b64 s[44:45], L_issue_x
  s_waitcnt vmcnt(8)
  s_barrier
  s_call_b64 s[44:45], L_xwait2
  s_call_b64 s[44:45], L_issue_x
  s_mov_b32 s43, 7
  s_call_b64 s[44:45], L_run_x8
  s_waitcnt vmcnt(8)
  s_barrier
  s_waitcnt vmcnt(0)
  s_barrier
  s_barrier
L_lend:
  s_sub_u32 s42, s3, 4
  s_and_b32 s43, s42, 1
  s_lshl_b32 s43, s43, 3
  s_lshr_b32 s42, s42, 1
  s_lshl_b32 s42, s42, 6
  s_add_u32 s42, s42, s43
  v_lshrrev_b32 v13, 4, v0
  v_add_u32 v13, s42, v13
  v_and_b32 v14, 15, v0
  v_mul_u32_u24 v15, 272, v13
  v_lshl_add_u32 v15, v14, 4, v15
  v_add_u32 v15, 98304, v15
  s_lshl_b32 s42, s16, 7
  v_add_u32 v13, s42, v13
  v_lshlrev_b32 v13, 11, v13
  v_lshl_add_u32 v13, v14, 4, v13
  s_lshl_b32 s42, s18, 8
  v_add_u32 v13, s42, v13
  s_mov_b32 s24, s10
  s_mov_b32 s25, s11
  s_mov_b32 s26, 0x800000
  s_mov_b32 s27, 0x20000
  s_barrier
  ds_read_b128 v[48:51], v15 offset:0
  ds_read_b128 v[52:55], v15 offset:1088
  s_waitcnt lgkmcnt(1)
  buffer_store_dwordx4 v[48:51], v13, s[24:27], 0 offen sc1
  v_add_u32 v13, 0x2000, v13
  s_waitcnt lgkmcnt(0)
  buffer_store_dwordx4 v[52:55], v13, s[24:27], 0 offen sc1
  v_add_u32 v13, 24576, v13
  v_add_u32 v15, 4352, v15
  s_barrier
  ds_read_b128 v[56:59], v15 offset:0
  ds_read_b128 v[60:63], v15 offset:1088
  s_waitcnt lgkmcnt(1)
  buffer_store_dwordx4 v[56:59], v13, s[24:27], 0 offen sc1
  v_add_u32 v13, 0x2000, v13
  s_waitcnt lgkmcnt(0)
  buffer_store_dwordx4 v[60:63], v13, s[24:27], 0 offen sc1
  v_add_u32 v13, 24576, v13
  v_add_u32 v15, 4352, v15
  s_barrier
  ds_read_b128 v[64:67], v15 offset:0
  ds_read_b128 v[68:71], v15 offset:1088
  s_waitcnt lgkmcnt(1)
  buffer_store_dwordx4 v[64:67], v13, s[24:27], 0 offen sc1
  v_add_u32 v13, 0x2000, v13
  s_waitcnt lgkmcnt(0)
  buffer_store_dwordx4 v[68:71], v13, s[24:27], 0 offen sc1
  s_barrier
  s_branch L_out
L_status:
  s_getreg_b32 s37, hwreg(HW_REG_XCC_ID, 0, 3)
  s_lshl_b32 s37, s37, 2
  s_lshl_b32 s37, 8, s37
  s_mov_b32 s42, 0
L_st_chk:
  v_readfirstlane_b32 s46, v14
  v_readfirstlane_b32 s47, v15
  s_add_u32 s42, s42, 1
  s_cmp_ge_u32 s46, 8
  s_cbranch_scc1 L_st_done
  s_cmp_ge_u32 s42, 0x100000
  s_cbranch_scc1 L_st_done
  s_sleep 2
  global_load_dwordx2 v[14:15], v13, s[12:13] sc1
  s_waitcnt vmcnt(0)
  s_branch L_st_chk
L_st_done:
  s_cmp_lg_u32 s47, s37
  s_cselect_b32 s40, 1, 0
  s_setpc_b64 s[44:45]
L_pub1:
  s_cmp_eq_u32 s60, 0
  s_cbranch_scc1 L_pub1b
  s_setpc_b64 s[44:45]
L_pub1b:
  s_mov_b32 s46, s34
  s_add_u32 s46, s46, 32768
  s_cmp_eq_u32 s46, 163840
  s_cselect_b32 s46, 0, s46
  s_cmp_eq_u32 s19, 0
  s_cbranch_scc1 L_pub0
  s_add_u32 s46, s46, 32768
  s_cmp_eq_u32 s46, 163840
  s_cselect_b32 s46, 0, s46
L_pub0:
  s_add_u32 s46, s46, 16384
  v_add_u32 v14, s46, v13
  ds_read_b128 v[32:35], v14 offset:0
  ds_read_b128 v[36:39], v14 offset:1024
  ds_read_b128 v[40:43], v14 offset:2048
  ds_read_b128 v[44:47], v14 offset:3072
  ds_read_b128 v[48:51], v14 offset:4096
  ds_read_b128 v[52:55], v14 offset:5120
  ds_read_b128 v[56:59], v14 offset:6144
  ds_read_b128 v[60:63], v14 offset:7168
  ds_read_b128 v[64:67], v14 offset:8192
  ds_read_b128 v[68:71], v14 offset:9216
  ds_read_b128 v[72:75], v14 offset:10240
  ds_read_b128 v[76:79], v14 offset:11264
  ds_read_b128 v[80:83], v14 offset:12288
  ds_read_b128 v[84:87], v14 offset:13312
  ds_read_b128 v[88:91], v14 offset:14336
  ds_read_b128 v[92:95], v14 offset:15360
  s_waitcnt lgkmcnt(15)
  buffer_store_dwordx4 v[32:35], v13, s[24:27], s58 offen offset:0 sc1
  s_waitcnt lgkmcnt(14)
  buffer_store_dwordx4 v[36:39], v13, s[24:27], s58 offen offset:1024 sc1
  s_waitcnt lgkmcnt(13)
  buffer_store_dwordx4 v[40:43], v13, s[24:27], s58 offen offset:2048 sc1
  s_waitcnt lgkmcnt(12)
  buffer_store_dwordx4 v[44:47], v13, s[24:27], s58 offen offset:3072 sc1
  s_waitcnt lgkmcnt(11)
  buffer_store_dwordx4 v[48:51], v17, s[24:27], s58 offen offset:0 sc1
  s_waitcnt lgkmcnt(10)
  buffer_store_dwordx4 v[52:55], v17, s[24:27], s58 offen offset:1024 sc1
  s_waitcnt lgkmcnt(9)
  buffer_store_dwordx4 v[56:59], v17, s[24:27], s58 offen offset:2048 sc1
  s_waitcnt lgkmcnt(8)
  buffer_store_dwordx4 v[60:63], v17, s[24:27], s58 offen offset:3072 sc1
  s_waitcnt lgkmcnt(7)
  buffer_store_dwordx4 v[64:67], v18, s[24:27], s58 offen offset:0 sc1
  s_waitcnt lgkmcnt(6)
  buffer_store_dwordx4 v[68:71], v18, s[24:27], s58 offen offset:1024 sc1
  s_waitcnt lgkmcnt(5)
  buffer_store_dwordx4 v[72:75], v18, s[24:27], s58 offen offset:2048 sc1
  s_waitcnt lgkmcnt(4)
  buffer_store_dwordx4 v[76:79], v18, s[24:27], s58 offen offset:3072 sc1
  s_waitcnt lgkmcnt(3)
  buffer_store_dwordx4 v[80:83], v19, s[24:27], s58 offen offset:0 sc1
  s_waitcnt lgkmcnt(2)
  buffer_store_dwordx4 v[84:87], v19, s[24:27], s58 offen offset:1024 sc1
  s_waitcnt lgkmcnt(1)
  buffer_store_dwordx4 v[88:91], v19, s[24:27], s58 offen offset:2048 sc1
  s_waitcnt lgkmcnt(0)
  buffer_store_dwordx4 v[92:95], v19, s[24:27], s58 offen offset:3072 sc1
  s_branch L_pub_fl
L_pub_ret:
  s_setpc_b64 s[44:45]
L_pub_fl:
  v_lshl_add_u32 v14, v0, 3, s59
  v_mov_b32 v15, 1
  s_waitcnt vmcnt(0)
  s_mov_b64 exec, 3
  global_store_dword v14, v15, s[14:15]
  s_mov_b64 exec, -1
  s_add_u32 s58, s58, 8388608
  s_setpc_b64 s[44:45]
L_pub4:
  s_cmp_eq_u32 s60, 0
  s_cbranch_scc0 L_pub_ret
  v_lshl_add_u32 v14, v0, 3, s59
  v_mov_b32 v15, 1
  s_mov_b64 exec, 3
  global_store_dword v14, v15, s[14:15] offset:128 sc1
  s_mov_b64 exec, -1
  s_add_u32 s59, s59, 256
  s_setpc_b64 s[44:45]
L_xwait:
  s_mov_b32 s30, s54
  s_lshl_b32 s57, s18, 1
  s_add_u32 s34, s34, 32768
  s_cmp_eq_u32 s34, 163840
  s_cselect_b32 s34, 0, s34
  s_add_u32 s34, s34, 32768
  s_cmp_eq_u32 s34, 163840
  s_cselect_b32 s34, 0, s34
  s_lshl_b32 s36, s30, s31
  s_add_u32 s36, s36, s32
  s_add_u32 s37, s34, s35
  s_mov_b32 m0, s37
  s_mov_b32 s46, s51
  s_branch L_xpoll0
L_xwait2:
  v_cmp_ne_u32 vcc, 0, v14
  s_mov_b32 s46, s48
  s_mov_b32 s47, s48
  s_or_b64 vcc, vcc, s[46:47]
  s_cmp_eq_u64 vcc, -1
  s_cbranch_scc1 L_xgo
L_xpoll0:
  s_mov_b32 s47, s46
  s_mov_b32 s42, 0
L_xpoll:
  global_load_dword v14, v13, s[14:15] sc1
L_xchk:
  s_waitcnt vmcnt(0)
  v_cmp_ne_u32 vcc, 0, v14
  s_add_u32 s42, s42, 1
  s_nop 0
  s_or_b64 vcc, vcc, s[46:47]
  s_cmp_eq_u64 vcc, -1
  s_cbranch_scc1 L_xgo
  s_cmp_ge_u32 s42, 0x100000
  s_cbranch_scc1 L_xgo
  s_branch L_xpoll
L_xgo:
  s_setpc_b64 s[44:45]

L_issue_p:
  buffer_load_dwordx4 v4, s[20:23], s36 offen offset:0 lds
  s_add_u32 s28, s37, 0x1000
  s_add_u32 s30, s30, 1
  buffer_load_dwordx4 v5, s[20:23], s36 offen offset:1024 lds
  s_and_b32 s30, s30, 15
  s_cmp_eq_u32 s30, s57
  buffer_load_dwordx4 v6, s[20:23], s36 offen offset:2048 lds
  s_cselect_b32 s42, 2, 0
  s_add_u32 s30, s30, s42
  buffer_load_dwordx4 v7, s[20:23], s36 offen offset:3072 lds
  s_mov_b32 m0, s28
  s_add_u32 s29, s36, s33
  buffer_load_dwordx4 v4, s[20:23], s29 offen offset:0 lds
  s_and_b32 s30, s30, 15
  s_add_u32 s34, s34, 32768
  buffer_load_dwordx4 v5, s[20:23], s29 offen offset:1024 lds
  s_cmp_eq_u32 s34, 163840
  s_cselect_b32 s34, 0, s34
  buffer_load_dwordx4 v6, s[20:23], s29 offen offset:2048 lds
  s_lshl_b32 s36, s30, s31
  s_add_u32 s36, s36, s32
  buffer_load_dwordx4 v7, s[20:23], s29 offen offset:3072 lds
  s_add_u32 s37, s34, s35
  s_mov_b32 m0, s37
  s_setpc_b64 s[44:45]
L_issue_c:
  buffer_load_dwordx4 v4, s[20:23], s36 offen offset:0 sc1 lds
  s_add_u32 s28, s37, 0x1000
  s_add_u32 s30, s30, 1
  buffer_load_dwordx4 v5, s[20:23], s36 offen offset:1024 sc1 lds
  s_and_b32 s30, s30, 15
  s_cmp_eq_u32 s30, s57
  buffer_load_dwordx4 v6, s[20:23], s36 offen offset:2048 sc1 lds
  s_cselect_b32 s42, 2, 0
  s_add_u32 s30, s30, s42
  buffer_load_dwordx4 v7, s[20:23], s36 offen offset:3072 sc1 lds
  s_mov_b32 m0, s28
  s_add_u32 s29, s36, s33
  buffer_load_dwordx4 v4, s[20:23], s29 offen offset:0 sc1 lds
  s_and_b32 s30, s30, 15
  s_add_u32 s34, s34, 32768
  buffer_load_dwordx4 v5, s[20:23], s29 offen offset:1024 sc1 lds
  s_cmp_eq_u32 s34, 163840
  s_cselect_b32 s34, 0, s34
  buffer_load_dwordx4 v6, s[20:23], s29 offen offset:2048 sc1 lds
  s_lshl_b32 s36, s30, s31
  s_add_u32 s36, s36, s32
  buffer_load_dwordx4 v7, s[20:23], s29 offen offset:3072 sc1 lds
  s_add_u32 s37, s34, s35
  s_mov_b32 m0, s37
  s_setpc_b64 s[44:45]
L_issue_x:
  s_cmp_lg_u32 s50, 0
  s_cbranch_scc1 L_issue_c
  s_branch L_issue_p
.p2align 3
L_run_p8:
  s_waitcnt vmcnt(8)
  s_barrier
  buffer_load_dwordx4 v4, s[20:23], s36 offen offset:0 lds
  s_add_u32 s28, s37, 0x1000
  s_add_u32 s30, s30, 1
  buffer_load_dwordx4 v5, s[20:23], s36 offen offset:1024 lds
  s_and_b32 s30, s30, 15
  s_cmp_eq_u32 s30, s57
  buffer_load_dwordx4 v6, s[20:23], s36 offen offset:2048 lds
  s_cselect_b32 s42, 2, 0
  s_add_u32 s30, s30, s42
  buffer_load_dwordx4 v7, s[20:23], s36 offen offset:3072 lds
  s_mov_b32 m0, s28
  s_add_u32 s29, s36, s33
  buffer_load_dwordx4 v4, s[20:23], s29 offen offset:0 lds
  s_and_b32 s30, s30, 15
  s_add_u32 s34, s34, 32768
  buffer_load_dwordx4 v5, s[20:23], s29 offen offset:1024 lds
  s_cmp_eq_u32 s34, 163840
  s_cselect_b32 s34, 0, s34
  buffer_load_dwordx4 v6, s[20:23], s29 offen offset:2048 lds
  s_lshl_b32 s36, s30, s31
  s_add_u32 s36, s36, s32
  buffer_load_dwordx4 v7, s[20:23], s29 offen offset:3072 lds
  s_add_u32 s37, s34, s35
  s_mov_b32 m0, s37
  s_sub_u32 s43, s43, 1
  s_cmp_lg_u32 s43, 0
  s_cbranch_scc1 L_run_p8
  s_setpc_b64 s[44:45]
.p2align 3
L_run_p16:
  s_waitcnt vmcnt(16)
  s_barrier
  buffer_load_dwordx4 v4, s[20:23], s36 offen offset:0 lds
  s_add_u32 s28, s37, 0x1000
  s_add_u32 s30, s30, 1
  buffer_load_dwordx4 v5, s[20:23], s36 offen offset:1024 lds
  s_and_b32 s30, s30, 15
  s_cmp_eq_u32 s30, s57
  buffer_load_dwordx4 v6, s[20:23], s36 offen offset:2048 lds
  s_cselect_b32 s42, 2, 0
  s_add_u32 s30, s30, s42
  buffer_load_dwordx4 v7, s[20:23], s36 offen offset:3072 lds
  s_mov_b32 m0, s28
  s_add_u32 s29, s36, s33
  buffer_load_dwordx4 v4, s[20:23], s29 offen offset:0 lds
  s_and_b32 s30, s30, 15
  s_add_u32 s34, s34, 32768
  buffer_load_dwordx4 v5, s[20:23], s29 offen offset:1024 lds
  s_cmp_eq_u32 s34, 163840
  s_cselect_b32 s34, 0, s34
  buffer_load_dwordx4 v6, s[20:23], s29 offen offset:2048 lds
  s_lshl_b32 s36, s30, s31
  s_add_u32 s36, s36, s32
  buffer_load_dwordx4 v7, s[20:23], s29 offen offset:3072 lds
  s_add_u32 s37, s34, s35
  s_mov_b32 m0, s37
  s_sub_u32 s43, s43, 1
  s_cmp_lg_u32 s43, 0
  s_cbranch_scc1 L_run_p16
  s_setpc_b64 s[44:45]
L_run_x8:
  s_cmp_lg_u32 s50, 0
  s_cbranch_scc1 L_run_c8
  s_branch L_run_p8
.p2align 3
L_run_c8:
  s_waitcnt vmcnt(8)
  s_barrier
  buffer_load_dwordx4 v4, s[20:23], s36 offen offset:0 sc1 lds
  s_add_u32 s28, s37, 0x1000
  s_add_u32 s30, s30, 1
  buffer_load_dwordx4 v5, s[20:23], s36 offen offset:1024 sc1 lds
  s_and_b32 s30, s30, 15
  s_cmp_eq_u32 s30, s57
  buffer_load_dwordx4 v6, s[20:23], s36 offen offset:2048 sc1 lds
  s_cselect_b32 s42, 2, 0
  s_add_u32 s30, s30, s42
  buffer_load_dwordx4 v7, s[20:23], s36 offen offset:3072 sc1 lds
  s_mov_b32 m0, s28
  s_add_u32 s29, s36, s33
  buffer_load_dwordx4 v4, s[20:23], s29 offen offset:0 sc1 lds
  s_and_b32 s30, s30, 15
  s_add_u32 s34, s34, 32768
  buffer_load_dwordx4 v5, s[20:23], s29 offen offset:1024 sc1 lds
  s_cmp_eq_u32 s34, 163840
  s_cselect_b32 s34, 0, s34
  buffer_load_dwordx4 v6, s[20:23], s29 offen offset:2048 sc1 lds
  s_lshl_b32 s36, s30, s31
  s_add_u32 s36, s36, s32
  buffer_load_dwordx4 v7, s[20:23], s29 offen offset:3072 sc1 lds
  s_add_u32 s37, s34, s35
  s_mov_b32 m0, s37
  s_sub_u32 s43, s43, 1
  s_cmp_lg_u32 s43, 0
  s_cbranch_scc1 L_run_c8
  s_setpc_b64 s[44:45]
L_compute:
  s_and_b32 s27, s3, 1
  s_lshr_b32 s28, s3, 1
  v_lshrrev_b32 v2, 4, v0
  s_lshl_b32 s30, s18, 8
  s_lshl_b32 s31, s27, 7
  s_add_u32 s30, s30, s31
  v_lshl_add_u32 v12, v2, 3, s30
  v_lshlrev_b32 v14, 7, v0
  s_getpc_b64 s[46:47]
L_pc:
  s_sub_u32 s46, s46, L_pc-standalone__cross_network_dcn__recsys_kernel
  s_subb_u32 s47, s47, 0
  s_waitcnt lgkmcnt(0)
  global_load_dwordx2 v[18:19], v12, s[8:9] offset:0
  global_load_dwordx2 v[22:23], v12, s[8:9] offset:32
  global_load_dwordx2 v[26:27], v12, s[8:9] offset:64
  global_load_dwordx2 v[30:31], v12, s[8:9] offset:96
  s_lshl_b32 s40, s16, 9
  s_lshl_b32 s41, s18, 4
  s_add_u32 s40, s40, s41
  s_add_u32 s40, s40, 16777216
  s_cmp_eq_u32 s3, 3
  s_cbranch_scc0 L_nopf
  v_min_u32 v14, L_end-standalone__cross_network_dcn__recsys_kernel, v14
  global_load_dword v1, v14, s[46:47]
  v_lshlrev_b32 v14, 7, v0
  v_add_u32 v14, 0x2000, v14
  v_min_u32 v14, L_end-standalone__cross_network_dcn__recsys_kernel, v14
  global_load_dword v1, v14, s[46:47]
L_nopf:

  s_cmp_lg_u32 s3, 0
  s_cbranch_scc1 L_nozero
  v_lshrrev_b32 v13, 2, v0
  v_and_b32 v14, 3, v0
  v_lshlrev_b32 v13, 7, v13
  v_lshl_add_u32 v13, v14, 2, v13
  v_add_u32 v13, s40, v13
  v_mov_b32 v14, 0
  s_mov_b64 exec, 0xffff
  global_store_dword v13, v14, s[14:15] sc1
  s_mov_b64 exec, -1
L_nozero:
  s_lshl_b32 s41, s3, 2
  s_add_u32 s40, s40, s41
  v_bfe_u32 v15, v0, 2, 2
  v_and_b32 v3, 3, v0
  v_lshlrev_b32 v13, 2, v2
  v_add_u32 v13, v13, v15
  v_and_b32 v14, 7, v13
  v_lshlrev_b32 v13, 8, v13
  v_lshl_add_u32 v13, v3, 3, v13
  s_lshl_b32 s29, s27, 2
  v_xor_b32 v14, s29, v14
  v_xor_b32 v15, 0, v14
  v_lshl_add_u32 v6, v15, 5, v13
  v_xor_b32 v15, 1, v14
  v_lshl_add_u32 v7, v15, 5, v13
  v_xor_b32 v15, 2, v14
  v_lshl_add_u32 v8, v15, 5, v13
  v_xor_b32 v15, 3, v14
  v_lshl_add_u32 v9, v15, 5, v13
  v_and_b32 v13, 15, v0
  v_lshrrev_b32 v14, 1, v13
  v_xor_b32 v15, v2, v14
  v_lshlrev_b32 v15, 4, v15
  v_lshl_add_u32 v15, v13, 7, v15
  s_lshl_b32 s29, s28, 13
  s_add_u32 s29, s29, 16384
  v_add_u32 v4, s29, v15
  v_xor_b32 v5, 64, v4
  v_lshrrev_b32 v15, 1, v2
  v_xor_b32 v15, v15, v14
  v_lshlrev_b32 v15, 4, v15
  v_lshl_add_u32 v15, v13, 7, v15
  v_and_b32 v14, 1, v2
  v_lshl_add_u32 v15, v14, 3, v15
  v_add_u32 v10, s29, v15
  s_lshl_b32 s30, s18, 1
  s_add_u32 s30, s30, s27
  s_lshl_b32 s30, s30, 14
  s_lshl_b32 s31, s28, 13
  s_add_u32 s30, s30, s31
  s_lshl_b32 s31, s16, 18
  s_add_u32 s30, s30, s31
  v_lshl_add_u32 v11, v0, 4, s30
  s_mov_b32 s20, s14
  s_mov_b32 s21, s15
  s_mov_b32 s22, 16777216
  s_mov_b32 s23, 0x20000
  s_lshl_b32 s30, s17, 1
  s_sub_u32 s30, s18, s30
  s_and_b32 s30, s30, 7
  s_cmp_lt_u32 s30, 4
  s_cselect_b32 s50, -1, 0
  s_mov_b32 s51, s50
  s_mov_b32 s33, 0xffff0000
  s_mov_b32 s34, 0
  s_mov_b32 s35, 0
  s_mov_b32 s37, 32768
  s_mov_b32 s38, 163840
  s_mov_b32 s39, 4294836224
  s_add_u32 s42, s18, s17
  s_and_b32 s42, s42, 1
  s_lshl_b32 s42, s42, 3
  s_lshl_b32 s48, s18, 1
  s_add_u32 s48, s48, s27
  s_sub_u32 s48, s48, s42
  s_and_b32 s48, s48, 15
  s_cmp_eq_u32 s3, 3
  s_cbranch_scc1 L_bw3
  s_cmp_eq_u32 s3, 0
  s_cbranch_scc1 L_bw0
  s_cmp_eq_u32 s3, 1
  s_cbranch_scc1 L_bw5
  s_waitcnt vmcnt(0)
  s_branch L_bw1
L_bw5:
  s_waitcnt vmcnt(0)
  s_branch L_bw1
L_bw3:
  s_waitcnt vmcnt(2)
  s_branch L_bw1
L_bw0:
  s_waitcnt vmcnt(1)
L_bw1:

  s_barrier

  ds_read_b64_tr_b16 v[32:33], v6 offset:0
  ds_read_b64_tr_b16 v[34:35], v6 offset:4096
  ds_read_b64_tr_b16 v[36:37], v7 offset:0
  ds_read_b64_tr_b16 v[38:39], v7 offset:4096
  ds_read_b64_tr_b16 v[40:41], v8 offset:0
  ds_read_b64_tr_b16 v[42:43], v8 offset:4096
  ds_read_b64_tr_b16 v[44:45], v9 offset:0
  ds_read_b64_tr_b16 v[46:47], v9 offset:4096
L_layer:
  ds_read_b128 v[64:67], v4 offset:0
  ds_read_b128 v[68:71], v4 offset:2048
  ds_read_b128 v[72:75], v4 offset:4096
  ds_read_b128 v[76:79], v4 offset:6144
  v_lshlrev_b32 v16, 16, v18
  v_and_b32 v17, s33, v18
  v_lshlrev_b32 v18, 16, v19
  v_and_b32 v19, s33, v19
  v_lshlrev_b32 v20, 16, v22
  v_and_b32 v21, s33, v22
  v_lshlrev_b32 v22, 16, v23
  v_and_b32 v23, s33, v23
  v_lshlrev_b32 v24, 16, v26
  v_and_b32 v25, s33, v26
  v_lshlrev_b32 v26, 16, v27
  v_and_b32 v27, s33, v27
  v_lshlrev_b32 v28, 16, v30
  v_and_b32 v29, s33, v30
  v_lshlrev_b32 v30, 16, v31
  v_and_b32 v31, s33, v31
  s_waitcnt lgkmcnt(3)
  v_mfma_f32_16x16x32_bf16 v[192:195], v[32:35], v[64:67], v[16:19]
  ds_read_b64_tr_b16 v[48:49], v6 offset:8192
  s_waitcnt lgkmcnt(3)
  v_mfma_f32_16x16x32_bf16 v[196:199], v[32:35], v[68:71], v[16:19]
  ds_read_b64_tr_b16 v[50:51], v6 offset:12288
  s_waitcnt lgkmcnt(3)
  v_mfma_f32_16x16x32_bf16 v[200:203], v[32:35], v[72:75], v[16:19]
  ds_read_b128 v[80:83], v5 offset:0
  s_waitcnt lgkmcnt(3)
  v_mfma_f32_16x16x32_bf16 v[204:207], v[32:35], v[76:79], v[16:19]
  ds_read_b128 v[84:87], v5 offset:2048
  v_mfma_f32_16x16x32_bf16 v[208:211], v[36:39], v[64:67], v[20:23]
  ds_read_b128 v[88:91], v5 offset:4096
  v_mfma_f32_16x16x32_bf16 v[212:215], v[36:39], v[68:71], v[20:23]
  ds_read_b128 v[92:95], v5 offset:6144
  v_mfma_f32_16x16x32_bf16 v[216:219], v[36:39], v[72:75], v[20:23]
  ds_read_b64_tr_b16 v[52:53], v7 offset:8192
  v_mfma_f32_16x16x32_bf16 v[220:223], v[36:39], v[76:79], v[20:23]
  ds_read_b64_tr_b16 v[54:55], v7 offset:12288
  s_cmp_eq_u32 s48, 50
  s_cbranch_scc1 L_ev_a
L_evr_a:
  v_mfma_f32_16x16x32_bf16 v[224:227], v[40:43], v[64:67], v[24:27]
  ds_read_b64_tr_b16 v[56:57], v8 offset:8192
  v_mfma_f32_16x16x32_bf16 v[228:231], v[40:43], v[68:71], v[24:27]
  ds_read_b64_tr_b16 v[58:59], v8 offset:12288
  v_mfma_f32_16x16x32_bf16 v[232:235], v[40:43], v[72:75], v[24:27]
  ds_read_b64_tr_b16 v[60:61], v9 offset:8192
  v_mfma_f32_16x16x32_bf16 v[236:239], v[40:43], v[76:79], v[24:27]
  ds_read_b64_tr_b16 v[62:63], v9 offset:12288
  v_mfma_f32_16x16x32_bf16 v[240:243], v[44:47], v[64:67], v[28:31]
  s_add_u32 s35, s35, s37
  s_cmp_eq_u32 s35, s38
  s_cselect_b32 s36, s39, s37
  s_cselect_b32 s35, 0, s35
  v_mfma_f32_16x16x32_bf16 v[244:247], v[44:47], v[68:71], v[28:31]
  v_add_u32 v6, s36, v6
  v_add_u32 v4, s36, v4
  v_mfma_f32_16x16x32_bf16 v[248:251], v[44:47], v[72:75], v[28:31]
  v_add_u32 v7, s36, v7
  v_add_u32 v5, s36, v5
  v_mfma_f32_16x16x32_bf16 v[252:255], v[44:47], v[76:79], v[28:31]
  v_add_u32 v8, s36, v8
  v_add_u32 v9, s36, v9
  s_cmp_eq_u32 s34, 0
  s_cbranch_scc1 L_reg
L_noreg:
  s_mov_b32 s41, 0
  s_waitcnt lgkmcnt(6)
  v_mfma_f32_16x16x32_bf16 v[192:195], v[48:51], v[80:83], v[192:195]
  s_cmp_eq_u32 s41, s48
  s_cbranch_scc1 L_ev_f
L_evr_f:
  v_mfma_f32_16x16x32_bf16 v[196:199], v[48:51], v[84:87], v[196:199]
  v_mfma_f32_16x16x32_bf16 v[200:203], v[48:51], v[88:91], v[200:203]
  ds_read_b64_tr_b16 v[32:33], v6 offset:0
  v_mfma_f32_16x16x32_bf16 v[204:207], v[48:51], v[92:95], v[204:207]
  ds_read_b64_tr_b16 v[34:35], v6 offset:4096
  s_waitcnt lgkmcnt(6)
  v_mfma_f32_16x16x32_bf16 v[208:211], v[52:55], v[80:83], v[208:211]
  ds_read_b128 v[64:67], v4 offset:0
  v_mfma_f32_16x16x32_bf16 v[212:215], v[52:55], v[84:87], v[212:215]
  ds_read_b128 v[68:71], v4 offset:2048
  v_mfma_f32_16x16x32_bf16 v[216:219], v[52:55], v[88:91], v[216:219]
  ds_read_b128 v[72:75], v4 offset:4096
  v_mfma_f32_16x16x32_bf16 v[220:223], v[52:55], v[92:95], v[220:223]
  ds_read_b128 v[76:79], v4 offset:6144
  s_waitcnt lgkmcnt(8)
  v_mfma_f32_16x16x32_bf16 v[224:227], v[56:59], v[80:83], v[224:227]
  v_mfma_f32_16x16x32_bf16 v[228:231], v[56:59], v[84:87], v[228:231]
  ds_read_b64_tr_b16 v[36:37], v7 offset:0
  v_mfma_f32_16x16x32_bf16 v[232:235], v[56:59], v[88:91], v[232:235]
  ds_read_b64_tr_b16 v[38:39], v7 offset:4096
  v_mfma_f32_16x16x32_bf16 v[236:239], v[56:59], v[92:95], v[236:239]
  ds_read_b64_tr_b16 v[40:41], v8 offset:0
  s_waitcnt lgkmcnt(9)
  v_mfma_f32_16x16x32_bf16 v[240:243], v[60:63], v[80:83], v[240:243]
  ds_read_b64_tr_b16 v[42:43], v8 offset:4096
  v_mfma_f32_16x16x32_bf16 v[244:247], v[60:63], v[84:87], v[244:247]
  ds_read_b64_tr_b16 v[44:45], v9 offset:0
  v_mfma_f32_16x16x32_bf16 v[248:251], v[60:63], v[88:91], v[248:251]
  ds_read_b64_tr_b16 v[46:47], v9 offset:4096
  v_mfma_f32_16x16x32_bf16 v[252:255], v[60:63], v[92:95], v[252:255]
  s_mov_b32 s41, 1
.p2align 6
L_stageA:
  s_waitcnt lgkmcnt(6)
  v_mfma_f32_16x16x32_bf16 v[192:195], v[32:35], v[64:67], v[192:195]
  ds_read_b64_tr_b16 v[48:49], v6 offset:8192
  v_mfma_f32_16x16x32_bf16 v[196:199], v[32:35], v[68:71], v[196:199]
  ds_read_b64_tr_b16 v[50:51], v6 offset:12288
  v_mfma_f32_16x16x32_bf16 v[200:203], v[32:35], v[72:75], v[200:203]
  ds_read_b128 v[80:83], v5 offset:0
  v_mfma_f32_16x16x32_bf16 v[204:207], v[32:35], v[76:79], v[204:207]
  ds_read_b128 v[84:87], v5 offset:2048
  s_waitcnt lgkmcnt(8)
  v_mfma_f32_16x16x32_bf16 v[208:211], v[36:39], v[64:67], v[208:211]
  ds_read_b128 v[88:91], v5 offset:4096
  v_mfma_f32_16x16x32_bf16 v[212:215], v[36:39], v[68:71], v[212:215]
  ds_read_b128 v[92:95], v5 offset:6144
  v_mfma_f32_16x16x32_bf16 v[216:219], v[36:39], v[72:75], v[216:219]
  ds_read_b64_tr_b16 v[52:53], v7 offset:8192
  v_mfma_f32_16x16x32_bf16 v[220:223], v[36:39], v[76:79], v[220:223]
  ds_read_b64_tr_b16 v[54:55], v7 offset:12288
  s_waitcnt lgkmcnt(10)
  v_mfma_f32_16x16x32_bf16 v[224:227], v[40:43], v[64:67], v[224:227]
  ds_read_b64_tr_b16 v[56:57], v8 offset:8192
  v_mfma_f32_16x16x32_bf16 v[228:231], v[40:43], v[68:71], v[228:231]
  ds_read_b64_tr_b16 v[58:59], v8 offset:12288
  v_mfma_f32_16x16x32_bf16 v[232:235], v[40:43], v[72:75], v[232:235]
  ds_read_b64_tr_b16 v[60:61], v9 offset:8192
  v_mfma_f32_16x16x32_bf16 v[236:239], v[40:43], v[76:79], v[236:239]
  ds_read_b64_tr_b16 v[62:63], v9 offset:12288
  s_waitcnt lgkmcnt(12)
  v_mfma_f32_16x16x32_bf16 v[240:243], v[44:47], v[64:67], v[240:243]
  s_add_u32 s35, s35, s37
  s_cmp_eq_u32 s35, s38
  s_cselect_b32 s36, s39, s37
  s_cselect_b32 s35, 0, s35
  v_mfma_f32_16x16x32_bf16 v[244:247], v[44:47], v[68:71], v[244:247]
  v_add_u32 v6, s36, v6
  v_add_u32 v4, s36, v4
  v_mfma_f32_16x16x32_bf16 v[248:251], v[44:47], v[72:75], v[248:251]
  v_add_u32 v7, s36, v7
  v_add_u32 v5, s36, v5
  v_mfma_f32_16x16x32_bf16 v[252:255], v[44:47], v[76:79], v[252:255]
  v_add_u32 v8, s36, v8
  v_add_u32 v9, s36, v9
  s_waitcnt lgkmcnt(6)
  v_mfma_f32_16x16x32_bf16 v[192:195], v[48:51], v[80:83], v[192:195]
  s_cmp_eq_u32 s41, s48
  s_cbranch_scc1 L_ev_m
L_evr_m:
  v_mfma_f32_16x16x32_bf16 v[196:199], v[48:51], v[84:87], v[196:199]
  s_add_u32 s41, s41, 1
  s_waitcnt lgkmcnt(0)
  s_barrier
  v_mfma_f32_16x16x32_bf16 v[200:203], v[48:51], v[88:91], v[200:203]
  ds_read_b64_tr_b16 v[32:33], v6 offset:0
  v_mfma_f32_16x16x32_bf16 v[204:207], v[48:51], v[92:95], v[204:207]
  ds_read_b64_tr_b16 v[34:35], v6 offset:4096
  v_mfma_f32_16x16x32_bf16 v[208:211], v[52:55], v[80:83], v[208:211]
  ds_read_b128 v[64:67], v4 offset:0
  v_mfma_f32_16x16x32_bf16 v[212:215], v[52:55], v[84:87], v[212:215]
  ds_read_b128 v[68:71], v4 offset:2048
  v_mfma_f32_16x16x32_bf16 v[216:219], v[52:55], v[88:91], v[216:219]
  ds_read_b128 v[72:75], v4 offset:4096
  v_mfma_f32_16x16x32_bf16 v[220:223], v[52:55], v[92:95], v[220:223]
  ds_read_b128 v[76:79], v4 offset:6144
  v_mfma_f32_16x16x32_bf16 v[224:227], v[56:59], v[80:83], v[224:227]
  v_mfma_f32_16x16x32_bf16 v[228:231], v[56:59], v[84:87], v[228:231]
  ds_read_b64_tr_b16 v[36:37], v7 offset:0
  v_mfma_f32_16x16x32_bf16 v[232:235], v[56:59], v[88:91], v[232:235]
  ds_read_b64_tr_b16 v[38:39], v7 offset:4096
  v_mfma_f32_16x16x32_bf16 v[236:239], v[56:59], v[92:95], v[236:239]
  ds_read_b64_tr_b16 v[40:41], v8 offset:0
  v_mfma_f32_16x16x32_bf16 v[240:243], v[60:63], v[80:83], v[240:243]
  ds_read_b64_tr_b16 v[42:43], v8 offset:4096
  v_mfma_f32_16x16x32_bf16 v[244:247], v[60:63], v[84:87], v[244:247]
  ds_read_b64_tr_b16 v[44:45], v9 offset:0
  v_mfma_f32_16x16x32_bf16 v[248:251], v[60:63], v[88:91], v[248:251]
  ds_read_b64_tr_b16 v[46:47], v9 offset:4096
  s_cmp_lt_u32 s41, 15
  v_mfma_f32_16x16x32_bf16 v[252:255], v[60:63], v[92:95], v[252:255]
  s_cbranch_scc1 L_stageA
  s_waitcnt lgkmcnt(6)
  v_mfma_f32_16x16x32_bf16 v[192:195], v[32:35], v[64:67], v[192:195]
  ds_read_b64_tr_b16 v[48:49], v6 offset:8192
  v_mfma_f32_16x16x32_bf16 v[196:199], v[32:35], v[68:71], v[196:199]
  ds_read_b64_tr_b16 v[50:51], v6 offset:12288
  v_mfma_f32_16x16x32_bf16 v[200:203], v[32:35], v[72:75], v[200:203]
  ds_read_b128 v[80:83], v5 offset:0
  v_mfma_f32_16x16x32_bf16 v[204:207], v[32:35], v[76:79], v[204:207]
  ds_read_b128 v[84:87], v5 offset:2048
  s_waitcnt lgkmcnt(8)
  v_mfma_f32_16x16x32_bf16 v[208:211], v[36:39], v[64:67], v[208:211]
  ds_read_b128 v[88:91], v5 offset:4096
  v_mfma_f32_16x16x32_bf16 v[212:215], v[36:39], v[68:71], v[212:215]
  ds_read_b128 v[92:95], v5 offset:6144
  v_mfma_f32_16x16x32_bf16 v[216:219], v[36:39], v[72:75], v[216:219]
  ds_read_b64_tr_b16 v[52:53], v7 offset:8192
  v_mfma_f32_16x16x32_bf16 v[220:223], v[36:39], v[76:79], v[220:223]
  ds_read_b64_tr_b16 v[54:55], v7 offset:12288
  s_waitcnt lgkmcnt(10)
  v_mfma_f32_16x16x32_bf16 v[224:227], v[40:43], v[64:67], v[224:227]
  ds_read_b64_tr_b16 v[56:57], v8 offset:8192
  v_mfma_f32_16x16x32_bf16 v[228:231], v[40:43], v[68:71], v[228:231]
  ds_read_b64_tr_b16 v[58:59], v8 offset:12288
  v_mfma_f32_16x16x32_bf16 v[232:235], v[40:43], v[72:75], v[232:235]
  ds_read_b64_tr_b16 v[60:61], v9 offset:8192
  v_mfma_f32_16x16x32_bf16 v[236:239], v[40:43], v[76:79], v[236:239]
  ds_read_b64_tr_b16 v[62:63], v9 offset:12288
  s_waitcnt lgkmcnt(12)
  v_mfma_f32_16x16x32_bf16 v[240:243], v[44:47], v[64:67], v[240:243]
  s_add_u32 s35, s35, s37
  s_cmp_eq_u32 s35, s38
  s_cselect_b32 s36, s39, s37
  s_cselect_b32 s35, 0, s35
  v_mfma_f32_16x16x32_bf16 v[244:247], v[44:47], v[68:71], v[244:247]
  v_add_u32 v6, s36, v6
  v_add_u32 v4, s36, v4
  v_mfma_f32_16x16x32_bf16 v[248:251], v[44:47], v[72:75], v[248:251]
  v_add_u32 v7, s36, v7
  v_add_u32 v5, s36, v5
  v_mfma_f32_16x16x32_bf16 v[252:255], v[44:47], v[76:79], v[252:255]
  v_add_u32 v8, s36, v8
  v_add_u32 v9, s36, v9
  s_waitcnt lgkmcnt(6)
  v_mfma_f32_16x16x32_bf16 v[192:195], v[48:51], v[80:83], v[192:195]
  s_cmp_eq_u32 s41, s48
  s_cbranch_scc1 L_ev_l
L_evr_l:
  v_mfma_f32_16x16x32_bf16 v[196:199], v[48:51], v[84:87], v[196:199]
  s_waitcnt lgkmcnt(0)
  s_barrier
  v_mfma_f32_16x16x32_bf16 v[200:203], v[48:51], v[88:91], v[200:203]
  ds_read_b64_tr_b16 v[32:33], v6 offset:0
  v_mfma_f32_16x16x32_bf16 v[204:207], v[48:51], v[92:95], v[204:207]
  ds_read_b64_tr_b16 v[34:35], v6 offset:4096
  s_lshl_b32 s42, s27, 15
  s_add_u32 s42, s42, s35
  s_sub_u32 s43, s42, s38
  v_mfma_f32_16x16x32_bf16 v[208:211], v[52:55], v[80:83], v[208:211]
  ds_read_b64_tr_b16 v[36:37], v7 offset:0
  s_cmp_ge_u32 s42, s38
  s_cselect_b32 s42, s43, s42
  s_lshl_b32 s43, s28, 13
  v_mfma_f32_16x16x32_bf16 v[212:215], v[52:55], v[84:87], v[212:215]
  ds_read_b64_tr_b16 v[38:39], v7 offset:4096
  s_add_u32 s42, s42, s43
  s_add_u32 s42, s42, 16384
  v_lshl_add_u32 v10, v0, 4, s42
  v_mfma_f32_16x16x32_bf16 v[216:219], v[52:55], v[88:91], v[216:219]
  ds_read_b64_tr_b16 v[40:41], v8 offset:0
  s_mov_b32 s43, s35
  s_add_u32 s43, s43, 32768
  s_cmp_eq_u32 s43, 163840
  s_cselect_b32 s43, 0, s43
  v_mfma_f32_16x16x32_bf16 v[220:223], v[52:55], v[92:95], v[220:223]
  ds_read_b64_tr_b16 v[42:43], v8 offset:4096
  s_add_u32 s43, s43, 32768
  s_cmp_eq_u32 s43, 163840
  s_cselect_b32 s43, 0, s43
  v_mfma_f32_16x16x32_bf16 v[224:227], v[56:59], v[80:83], v[224:227]
  ds_read_b64_tr_b16 v[44:45], v9 offset:0
  s_lshl_b32 s42, s27, 11
  s_add_u32 s43, s43, s42
  s_add_u32 s43, s43, 16384
  v_mfma_f32_16x16x32_bf16 v[228:231], v[56:59], v[84:87], v[228:231]
  ds_read_b64_tr_b16 v[46:47], v9 offset:4096
  v_lshl_add_u32 v13, v0, 3, s43
  v_add_u32 v15, 0x1000, v11
  v_mfma_f32_16x16x32_bf16 v[232:235], v[56:59], v[88:91], v[232:235]
  s_lshl_b32 s44, s34, 23
  s_mov_b64 vcc, s[50:51]
  v_mfma_f32_16x16x32_bf16 v[236:239], v[56:59], v[92:95], v[236:239]
  ds_read_b64 v[18:19], v13 offset:0
  v_mfma_f32_16x16x32_bf16 v[240:243], v[60:63], v[80:83], v[240:243]
  ds_read_b64 v[22:23], v13 offset:512
  v_mfma_f32_16x16x32_bf16 v[244:247], v[60:63], v[84:87], v[244:247]
  ds_read_b64 v[26:27], v13 offset:1024
  v_mfma_f32_16x16x32_bf16 v[248:251], v[60:63], v[88:91], v[248:251]
  ds_read_b64 v[30:31], v13 offset:1536
  v_mfma_f32_16x16x32_bf16 v[252:255], v[60:63], v[92:95], v[252:255]

  s_cmp_eq_u32 s34, 2
  s_cbranch_scc1 L_final
  s_cmp_eq_u32 s34, 0
  s_cbranch_scc0 L_epi1
.p2align 3
  v_lshlrev_b32 v128, 16, v96
  v_and_b32 v129, s33, v96
  v_lshlrev_b32 v130, 16, v97
  v_and_b32 v131, s33, v97
  v_lshlrev_b32 v144, 16, v98
  v_and_b32 v145, s33, v98
  v_lshlrev_b32 v146, 16, v99
  v_and_b32 v147, s33, v99
  v_lshlrev_b32 v132, 16, v104
  v_and_b32 v133, s33, v104
  v_lshlrev_b32 v134, 16, v105
  v_and_b32 v135, s33, v105
  v_lshlrev_b32 v148, 16, v106
  v_and_b32 v149, s33, v106
  v_lshlrev_b32 v150, 16, v107
  v_and_b32 v151, s33, v107
  v_pk_fma_f32 v[64:65], v[128:129], v[192:193], v[128:129]
  v_pk_fma_f32 v[66:67], v[130:131], v[194:195], v[130:131]
  v_pk_fma_f32 v[68:69], v[144:145], v[208:209], v[144:145]
  v_pk_fma_f32 v[70:71], v[146:147], v[210:211], v[146:147]
  v_lshlrev_b32 v136, 16, v112
  v_and_b32 v137, s33, v112
  v_lshlrev_b32 v138, 16, v113
  v_and_b32 v139, s33, v113
  v_lshlrev_b32 v152, 16, v114
  v_and_b32 v153, s33, v114
  v_lshlrev_b32 v154, 16, v115
  v_and_b32 v155, s33, v115
  v_pk_fma_f32 v[72:73], v[132:133], v[196:197], v[132:133]
  v_pk_fma_f32 v[74:75], v[134:135], v[198:199], v[134:135]
  v_pk_fma_f32 v[76:77], v[148:149], v[212:213], v[148:149]
  v_pk_fma_f32 v[78:79], v[150:151], v[214:215], v[150:151]
  v_cvt_pk_bf16_f32 v96, v64, v65
  v_cvt_pk_bf16_f32 v97, v66, v67
  v_cvt_pk_bf16_f32 v98, v68, v69
  v_cvt_pk_bf16_f32 v99, v70, v71
  v_lshlrev_b32 v140, 16, v120
  v_and_b32 v141, s33, v120
  v_lshlrev_b32 v142, 16, v121
  v_and_b32 v143, s33, v121
  v_lshlrev_b32 v156, 16, v122
  v_and_b32 v157, s33, v122
  v_lshlrev_b32 v158, 16, v123
  v_and_b32 v159, s33, v123
  v_pk_fma_f32 v[80:81], v[136:137], v[200:201], v[136:137]
  v_pk_fma_f32 v[82:83], v[138:139], v[202:203], v[138:139]
  v_pk_fma_f32 v[84:85], v[152:153], v[216:217], v[152:153]
  v_pk_fma_f32 v[86:87], v[154:155], v[218:219], v[154:155]
  v_cvt_pk_bf16_f32 v104, v72, v73
  v_cvt_pk_bf16_f32 v105, v74, v75
  v_cvt_pk_bf16_f32 v106, v76, v77
  v_cvt_pk_bf16_f32 v107, v78, v79
  s_cbranch_vccz L_nw1
  buffer_store_dwordx4 v[96:99], v11, s[20:23], s44 offen offset:0 sc1
  s_branch L_ns1
  L_nw1:
  ds_write_b128 v10, v[96:99] offset:0
  L_ns1:
  v_lshlrev_b32 v160, 16, v100
  v_and_b32 v161, s33, v100
  v_lshlrev_b32 v162, 16, v101
  v_and_b32 v163, s33, v101
  v_lshlrev_b32 v176, 16, v102
  v_and_b32 v177, s33, v102
  v_lshlrev_b32 v178, 16, v103
  v_and_b32 v179, s33, v103
  v_pk_fma_f32 v[88:89], v[140:141], v[204:205], v[140:141]
  v_pk_fma_f32 v[90:91], v[142:143], v[206:207], v[142:143]
  v_pk_fma_f32 v[92:93], v[156:157], v[220:221], v[156:157]
  v_pk_fma_f32 v[94:95], v[158:159], v[222:223], v[158:159]
  v_cvt_pk_bf16_f32 v112, v80, v81
  v_cvt_pk_bf16_f32 v113, v82, v83
  v_cvt_pk_bf16_f32 v114, v84, v85
  v_cvt_pk_bf16_f32 v115, v86, v87
  s_cbranch_vccz L_nw2
  buffer_store_dwordx4 v[104:107], v11, s[20:23], s44 offen offset:2048 sc1
  s_branch L_ns2
  L_nw2:
  ds_write_b128 v10, v[104:107] offset:2048
  L_ns2:
  v_lshlrev_b32 v164, 16, v108
  v_and_b32 v165, s33, v108
  v_lshlrev_b32 v166, 16, v109
  v_and_b32 v167, s33, v109
  v_lshlrev_b32 v180, 16, v110
  v_and_b32 v181, s33, v110
  v_lshlrev_b32 v182, 16, v111
  v_and_b32 v183, s33, v111
  v_pk_fma_f32 v[48:49], v[160:161], v[224:225], v[160:161]
  v_pk_fma_f32 v[50:51], v[162:163], v[226:227], v[162:163]
  v_pk_fma_f32 v[52:53], v[176:177], v[240:241], v[176:177]
  v_pk_fma_f32 v[54:55], v[178:179], v[242:243], v[178:179]
  v_cvt_pk_bf16_f32 v120, v88, v89
  v_cvt_pk_bf16_f32 v121, v90, v91
  v_cvt_pk_bf16_f32 v122, v92, v93
  v_cvt_pk_bf16_f32 v123, v94, v95
  s_cbranch_vccz L_nw3
  buffer_store_dwordx4 v[112:115], v15, s[20:23], s44 offen offset:0 sc1
  s_branch L_ns3
  L_nw3:
  ds_write_b128 v10, v[112:115] offset:4096
  L_ns3:
  v_lshlrev_b32 v168, 16, v116
  v_and_b32 v169, s33, v116
  v_lshlrev_b32 v170, 16, v117
  v_and_b32 v171, s33, v117
  v_lshlrev_b32 v184, 16, v118
  v_and_b32 v185, s33, v118
  v_lshlrev_b32 v186, 16, v119
  v_and_b32 v187, s33, v119
  v_pk_fma_f32 v[56:57], v[164:165], v[228:229], v[164:165]
  v_pk_fma_f32 v[58:59], v[166:167], v[230:231], v[166:167]
  v_pk_fma_f32 v[60:61], v[180:181], v[244:245], v[180:181]
  v_pk_fma_f32 v[62:63], v[182:183], v[246:247], v[182:183]
  v_cvt_pk_bf16_f32 v100, v48, v49
  v_cvt_pk_bf16_f32 v101, v50, v51
  v_cvt_pk_bf16_f32 v102, v52, v53
  v_cvt_pk_bf16_f32 v103, v54, v55
  s_cbranch_vccz L_nw4
  buffer_store_dwordx4 v[120:123], v15, s[20:23], s44 offen offset:2048 sc1
  s_branch L_ns4
  L_nw4:
  ds_write_b128 v10, v[120:123] offset:6144
  L_ns4:
  v_lshlrev_b32 v172, 16, v124
  v_and_b32 v173, s33, v124
  v_lshlrev_b32 v174, 16, v125
  v_and_b32 v175, s33, v125
  v_lshlrev_b32 v188, 16, v126
  v_and_b32 v189, s33, v126
  v_lshlrev_b32 v190, 16, v127
  v_and_b32 v191, s33, v127
  v_pk_fma_f32 v[64:65], v[168:169], v[232:233], v[168:169]
  v_pk_fma_f32 v[66:67], v[170:171], v[234:235], v[170:171]
  v_pk_fma_f32 v[68:69], v[184:185], v[248:249], v[184:185]
  v_pk_fma_f32 v[70:71], v[186:187], v[250:251], v[186:187]
  v_cvt_pk_bf16_f32 v108, v56, v57
  v_cvt_pk_bf16_f32 v109, v58, v59
  v_cvt_pk_bf16_f32 v110, v60, v61
  v_cvt_pk_bf16_f32 v111, v62, v63
  s_cbranch_vccz L_nw5
  buffer_store_dwordx4 v[100:103], v11, s[20:23], s44 offen offset:1024 sc1
  s_branch L_ns5
  L_nw5:
  ds_write_b128 v10, v[100:103] offset:1024
  L_ns5:
  v_pk_fma_f32 v[72:73], v[172:173], v[236:237], v[172:173]
  v_pk_fma_f32 v[74:75], v[174:175], v[238:239], v[174:175]
  v_pk_fma_f32 v[76:77], v[188:189], v[252:253], v[188:189]
  v_pk_fma_f32 v[78:79], v[190:191], v[254:255], v[190:191]
  v_cvt_pk_bf16_f32 v116, v64, v65
  v_cvt_pk_bf16_f32 v117, v66, v67
  v_cvt_pk_bf16_f32 v118, v68, v69
  v_cvt_pk_bf16_f32 v119, v70, v71
  s_cbranch_vccz L_nw6
  buffer_store_dwordx4 v[108:111], v11, s[20:23], s44 offen offset:3072 sc1
  s_branch L_ns6
  L_nw6:
  ds_write_b128 v10, v[108:111] offset:3072
  L_ns6:
  v_cvt_pk_bf16_f32 v124, v72, v73
  v_cvt_pk_bf16_f32 v125, v74, v75
  v_cvt_pk_bf16_f32 v126, v76, v77
  v_cvt_pk_bf16_f32 v127, v78, v79
  s_cbranch_vccz L_nw7
  buffer_store_dwordx4 v[116:119], v15, s[20:23], s44 offen offset:1024 sc1
  s_branch L_ns7
  L_nw7:
  ds_write_b128 v10, v[116:119] offset:5120
  L_ns7:
  s_cbranch_vccz L_nw8
  buffer_store_dwordx4 v[124:127], v15, s[20:23], s44 offen offset:3072 sc1
  s_branch L_ns8
  L_nw8:
  ds_write_b128 v10, v[124:127] offset:7168
  L_ns8:
  s_branch L_epi_tail
.p2align 3
L_epi1:
  v_lshlrev_b32 v64, 16, v96
  v_and_b32 v65, s33, v96
  v_lshlrev_b32 v66, 16, v97
  v_and_b32 v67, s33, v97
  v_lshlrev_b32 v68, 16, v98
  v_and_b32 v69, s33, v98
  v_lshlrev_b32 v70, 16, v99
  v_and_b32 v71, s33, v99
  v_lshlrev_b32 v72, 16, v104
  v_and_b32 v73, s33, v104
  v_lshlrev_b32 v74, 16, v105
  v_and_b32 v75, s33, v105
  v_lshlrev_b32 v76, 16, v106
  v_and_b32 v77, s33, v106
  v_lshlrev_b32 v78, 16, v107
  v_and_b32 v79, s33, v107
  v_pk_fma_f32 v[64:65], v[128:129], v[192:193], v[64:65]
  v_pk_fma_f32 v[66:67], v[130:131], v[194:195], v[66:67]
  v_pk_fma_f32 v[68:69], v[144:145], v[208:209], v[68:69]
  v_pk_fma_f32 v[70:71], v[146:147], v[210:211], v[70:71]
  v_lshlrev_b32 v80, 16, v112
  v_and_b32 v81, s33, v112
  v_lshlrev_b32 v82, 16, v113
  v_and_b32 v83, s33, v113
  v_lshlrev_b32 v84, 16, v114
  v_and_b32 v85, s33, v114
  v_lshlrev_b32 v86, 16, v115
  v_and_b32 v87, s33, v115
  v_pk_fma_f32 v[72:73], v[132:133], v[196:197], v[72:73]
  v_pk_fma_f32 v[74:75], v[134:135], v[198:199], v[74:75]
  v_pk_fma_f32 v[76:77], v[148:149], v[212:213], v[76:77]
  v_pk_fma_f32 v[78:79], v[150:151], v[214:215], v[78:79]
  v_cvt_pk_bf16_f32 v96, v64, v65
  v_cvt_pk_bf16_f32 v97, v66, v67
  v_cvt_pk_bf16_f32 v98, v68, v69
  v_cvt_pk_bf16_f32 v99, v70, v71
  v_lshlrev_b32 v88, 16, v120
  v_and_b32 v89, s33, v120
  v_lshlrev_b32 v90, 16, v121
  v_and_b32 v91, s33, v121
  v_lshlrev_b32 v92, 16, v122
  v_and_b32 v93, s33, v122
  v_lshlrev_b32 v94, 16, v123
  v_and_b32 v95, s33, v123
  v_pk_fma_f32 v[80:81], v[136:137], v[200:201], v[80:81]
  v_pk_fma_f32 v[82:83], v[138:139], v[202:203], v[82:83]
  v_pk_fma_f32 v[84:85], v[152:153], v[216:217], v[84:85]
  v_pk_fma_f32 v[86:87], v[154:155], v[218:219], v[86:87]
  v_cvt_pk_bf16_f32 v104, v72, v73
  v_cvt_pk_bf16_f32 v105, v74, v75
  v_cvt_pk_bf16_f32 v106, v76, v77
  v_cvt_pk_bf16_f32 v107, v78, v79
  s_cbranch_vccz L_nw9
  buffer_store_dwordx4 v[96:99], v11, s[20:23], s44 offen offset:0 sc1
  s_branch L_ns9
  L_nw9:
  ds_write_b128 v10, v[96:99] offset:0
  L_ns9:
  v_lshlrev_b32 v48, 16, v100
  v_and_b32 v49, s33, v100
  v_lshlrev_b32 v50, 16, v101
  v_and_b32 v51, s33, v101
  v_lshlrev_b32 v52, 16, v102
  v_and_b32 v53, s33, v102
  v_lshlrev_b32 v54, 16, v103
  v_and_b32 v55, s33, v103
  v_pk_fma_f32 v[88:89], v[140:141], v[204:205], v[88:89]
  v_pk_fma_f32 v[90:91], v[142:143], v[206:207], v[90:91]
  v_pk_fma_f32 v[92:93], v[156:157], v[220:221], v[92:93]
  v_pk_fma_f32 v[94:95], v[158:159], v[222:223], v[94:95]
  v_cvt_pk_bf16_f32 v112, v80, v81
  v_cvt_pk_bf16_f32 v113, v82, v83
  v_cvt_pk_bf16_f32 v114, v84, v85
  v_cvt_pk_bf16_f32 v115, v86, v87
  s_cbranch_vccz L_nw10
  buffer_store_dwordx4 v[104:107], v11, s[20:23], s44 offen offset:2048 sc1
  s_branch L_ns10
  L_nw10:
  ds_write_b128 v10, v[104:107] offset:2048
  L_ns10:
  v_lshlrev_b32 v56, 16, v108
  v_and_b32 v57, s33, v108
  v_lshlrev_b32 v58, 16, v109
  v_and_b32 v59, s33, v109
  v_lshlrev_b32 v60, 16, v110
  v_and_b32 v61, s33, v110
  v_lshlrev_b32 v62, 16, v111
  v_and_b32 v63, s33, v111
  v_pk_fma_f32 v[48:49], v[160:161], v[224:225], v[48:49]
  v_pk_fma_f32 v[50:51], v[162:163], v[226:227], v[50:51]
  v_pk_fma_f32 v[52:53], v[176:177], v[240:241], v[52:53]
  v_pk_fma_f32 v[54:55], v[178:179], v[242:243], v[54:55]
  v_cvt_pk_bf16_f32 v120, v88, v89
  v_cvt_pk_bf16_f32 v121, v90, v91
  v_cvt_pk_bf16_f32 v122, v92, v93
  v_cvt_pk_bf16_f32 v123, v94, v95
  s_cbranch_vccz L_nw11
  buffer_store_dwordx4 v[112:115], v15, s[20:23], s44 offen offset:0 sc1
  s_branch L_ns11
  L_nw11:
  ds_write_b128 v10, v[112:115] offset:4096
  L_ns11:
  v_lshlrev_b32 v64, 16, v116
  v_and_b32 v65, s33, v116
  v_lshlrev_b32 v66, 16, v117
  v_and_b32 v67, s33, v117
  v_lshlrev_b32 v68, 16, v118
  v_and_b32 v69, s33, v118
  v_lshlrev_b32 v70, 16, v119
  v_and_b32 v71, s33, v119
  v_pk_fma_f32 v[56:57], v[164:165], v[228:229], v[56:57]
  v_pk_fma_f32 v[58:59], v[166:167], v[230:231], v[58:59]
  v_pk_fma_f32 v[60:61], v[180:181], v[244:245], v[60:61]
  v_pk_fma_f32 v[62:63], v[182:183], v[246:247], v[62:63]
  v_cvt_pk_bf16_f32 v100, v48, v49
  v_cvt_pk_bf16_f32 v101, v50, v51
  v_cvt_pk_bf16_f32 v102, v52, v53
  v_cvt_pk_bf16_f32 v103, v54, v55
  s_cbranch_vccz L_nw12
  buffer_store_dwordx4 v[120:123], v15, s[20:23], s44 offen offset:2048 sc1
  s_branch L_ns12
  L_nw12:
  ds_write_b128 v10, v[120:123] offset:6144
  L_ns12:
  v_lshlrev_b32 v72, 16, v124
  v_and_b32 v73, s33, v124
  v_lshlrev_b32 v74, 16, v125
  v_and_b32 v75, s33, v125
  v_lshlrev_b32 v76, 16, v126
  v_and_b32 v77, s33, v126
  v_lshlrev_b32 v78, 16, v127
  v_and_b32 v79, s33, v127
  v_pk_fma_f32 v[64:65], v[168:169], v[232:233], v[64:65]
  v_pk_fma_f32 v[66:67], v[170:171], v[234:235], v[66:67]
  v_pk_fma_f32 v[68:69], v[184:185], v[248:249], v[68:69]
  v_pk_fma_f32 v[70:71], v[186:187], v[250:251], v[70:71]
  v_cvt_pk_bf16_f32 v108, v56, v57
  v_cvt_pk_bf16_f32 v109, v58, v59
  v_cvt_pk_bf16_f32 v110, v60, v61
  v_cvt_pk_bf16_f32 v111, v62, v63
  s_cbranch_vccz L_nw13
  buffer_store_dwordx4 v[100:103], v11, s[20:23], s44 offen offset:1024 sc1
  s_branch L_ns13
  L_nw13:
  ds_write_b128 v10, v[100:103] offset:1024
  L_ns13:
  v_pk_fma_f32 v[72:73], v[172:173], v[236:237], v[72:73]
  v_pk_fma_f32 v[74:75], v[174:175], v[238:239], v[74:75]
  v_pk_fma_f32 v[76:77], v[188:189], v[252:253], v[76:77]
  v_pk_fma_f32 v[78:79], v[190:191], v[254:255], v[78:79]
  v_cvt_pk_bf16_f32 v116, v64, v65
  v_cvt_pk_bf16_f32 v117, v66, v67
  v_cvt_pk_bf16_f32 v118, v68, v69
  v_cvt_pk_bf16_f32 v119, v70, v71
  s_cbranch_vccz L_nw14
  buffer_store_dwordx4 v[108:111], v11, s[20:23], s44 offen offset:3072 sc1
  s_branch L_ns14
  L_nw14:
  ds_write_b128 v10, v[108:111] offset:3072
  L_ns14:
  v_cvt_pk_bf16_f32 v124, v72, v73
  v_cvt_pk_bf16_f32 v125, v74, v75
  v_cvt_pk_bf16_f32 v126, v76, v77
  v_cvt_pk_bf16_f32 v127, v78, v79
  s_cbranch_vccz L_nw15
  buffer_store_dwordx4 v[116:119], v15, s[20:23], s44 offen offset:1024 sc1
  s_branch L_ns15
  L_nw15:
  ds_write_b128 v10, v[116:119] offset:5120
  L_ns15:
  s_cbranch_vccz L_nw16
  buffer_store_dwordx4 v[124:127], v15, s[20:23], s44 offen offset:3072 sc1
  s_branch L_ns16
  L_nw16:
  ds_write_b128 v10, v[124:127] offset:7168
  L_ns16:
L_epi_tail:
  s_cbranch_vccz L_nowr
  ds_write_b128 v10, v[96:99] offset:0
  ds_write_b128 v10, v[104:107] offset:2048
  ds_write_b128 v10, v[112:115] offset:4096
  ds_write_b128 v10, v[120:123] offset:6144
  ds_write_b128 v10, v[100:103] offset:1024
  ds_write_b128 v10, v[108:111] offset:3072
  ds_write_b128 v10, v[116:119] offset:5120
  ds_write_b128 v10, v[124:127] offset:7168
L_nowr:
  s_lshl_b32 s42, s28, 13
  s_add_u32 s42, s42, s35
  s_add_u32 s42, s42, 16384
  v_lshl_add_u32 v4, v0, 4, s42
  v_add_u32 v5, 0x400, v4
  s_add_u32 s34, s34, 1
  s_cmp_lg_u32 s50, 0
  s_cselect_b32 s48, 50, 99
  s_waitcnt lgkmcnt(0)
  s_barrier

  s_branch L_layer
L_reg:
  s_cmp_lg_u32 s3, 0
  s_cbranch_scc1 L_noreg
  s_getreg_b32 s42, hwreg(HW_REG_XCC_ID, 0, 3)
  s_lshl_b32 s42, s42, 2
  s_lshl_b32 s42, 1, s42
  s_lshl_b32 s43, s16, 3
  v_mov_b32 v13, s43
  v_mov_b32 v14, 1
  v_mov_b32 v15, s42
  s_mov_b64 exec, 1
  s_waitcnt vmcnt(0)
  global_atomic_add_x2 v13, v[14:15], s[12:13]
  s_mov_b64 exec, -1
  s_branch L_noreg
L_ev_a:
  s_mov_b32 s41, 0
  s_call_b64 s[52:53], L_event
  s_branch L_evr_a
L_ev_f:
  s_call_b64 s[52:53], L_event
  s_branch L_evr_f
L_ev_m:
  s_call_b64 s[52:53], L_event
  s_branch L_evr_m
L_ev_l:
  s_call_b64 s[52:53], L_event
  s_branch L_evr_l
L_event:
  s_mov_b32 s48, 99
  s_cmp_eq_u32 s34, 0
  s_cbranch_scc1 L_ev_x0
  v_mov_b32 v13, s40
  v_mov_b32 v14, 1
  s_cmp_eq_u32 s41, 1
  s_cbranch_scc1 L_ev_coh

  s_waitcnt vmcnt(0)

  s_mov_b64 exec, 1
  global_store_dword v13, v14, s[14:15]
  s_mov_b64 exec, -1
  s_mov_b32 s48, 1
  s_setpc_b64 s[52:53]
L_ev_coh:
  s_mov_b64 exec, 1
  global_store_dword v13, v14, s[14:15] offset:128 sc1
  s_mov_b64 exec, -1
  s_add_u32 s40, s40, 256
  s_setpc_b64 s[52:53]
L_ev_x0:
  s_sub_u32 s42, s35, s37
  s_cmp_eq_u32 s35, 0
  s_cselect_b32 s42, 131072, s42
  v_add_u32 v2, s42, v10
  ds_read_b64 v[96:97], v2 offset:0
  ds_read_b64 v[104:105], v2 offset:2048
  ds_read_b64 v[112:113], v2 offset:4096
  ds_read_b64 v[120:121], v2 offset:6144
  v_xor_b32 v13, 32, v2
  ds_read_b64 v[98:99], v13 offset:0
  ds_read_b64 v[106:107], v13 offset:2048
  ds_read_b64 v[114:115], v13 offset:4096
  ds_read_b64 v[122:123], v13 offset:6144
  v_xor_b32 v13, 64, v2
  ds_read_b64 v[100:101], v13 offset:0
  ds_read_b64 v[108:109], v13 offset:2048
  ds_read_b64 v[116:117], v13 offset:4096
  ds_read_b64 v[124:125], v13 offset:6144
  v_xor_b32 v13, 96, v2
  ds_read_b64 v[102:103], v13 offset:0
  ds_read_b64 v[110:111], v13 offset:2048
  ds_read_b64 v[118:119], v13 offset:4096
  ds_read_b64 v[126:127], v13 offset:6144
  s_setpc_b64 s[52:53]
L_final:
  v_and_b32 v13, 15, v0
  v_lshrrev_b32 v14, 4, v0
  v_mul_u32_u24 v13, 272, v13
  v_lshl_add_u32 v13, v14, 3, v13
  s_mul_i32 s42, s28, 17408
  s_lshl_b32 s43, s27, 7
  s_add_u32 s42, s42, s43
  s_add_u32 s42, s42, 98304
  v_add_u32 v10, s42, v13
.p2align 3
  v_lshlrev_b32 v64, 16, v96
  v_and_b32 v65, s33, v96
  v_lshlrev_b32 v66, 16, v97
  v_and_b32 v67, s33, v97
  v_lshlrev_b32 v68, 16, v98
  v_and_b32 v69, s33, v98
  v_lshlrev_b32 v70, 16, v99
  v_and_b32 v71, s33, v99
  v_lshlrev_b32 v72, 16, v100
  v_and_b32 v73, s33, v100
  v_lshlrev_b32 v74, 16, v101
  v_and_b32 v75, s33, v101
  v_lshlrev_b32 v76, 16, v102
  v_and_b32 v77, s33, v102
  v_lshlrev_b32 v78, 16, v103
  v_and_b32 v79, s33, v103
  v_pk_fma_f32 v[64:65], v[128:129], v[192:193], v[64:65]
  v_pk_fma_f32 v[66:67], v[130:131], v[194:195], v[66:67]
  v_pk_fma_f32 v[68:69], v[144:145], v[208:209], v[68:69]
  v_pk_fma_f32 v[70:71], v[146:147], v[210:211], v[70:71]
  v_lshlrev_b32 v80, 16, v104
  v_and_b32 v81, s33, v104
  v_lshlrev_b32 v82, 16, v105
  v_and_b32 v83, s33, v105
  v_lshlrev_b32 v84, 16, v106
  v_and_b32 v85, s33, v106
  v_lshlrev_b32 v86, 16, v107
  v_and_b32 v87, s33, v107
  v_pk_fma_f32 v[72:73], v[160:161], v[224:225], v[72:73]
  v_pk_fma_f32 v[74:75], v[162:163], v[226:227], v[74:75]
  v_pk_fma_f32 v[76:77], v[176:177], v[240:241], v[76:77]
  v_pk_fma_f32 v[78:79], v[178:179], v[242:243], v[78:79]
  v_cvt_pk_bf16_f32 v96, v64, v65
  v_cvt_pk_bf16_f32 v97, v66, v67
  v_cvt_pk_bf16_f32 v98, v68, v69
  v_cvt_pk_bf16_f32 v99, v70, v71
  v_lshlrev_b32 v88, 16, v108
  v_and_b32 v89, s33, v108
  v_lshlrev_b32 v90, 16, v109
  v_and_b32 v91, s33, v109
  v_lshlrev_b32 v92, 16, v110
  v_and_b32 v93, s33, v110
  v_lshlrev_b32 v94, 16, v111
  v_and_b32 v95, s33, v111
  v_pk_fma_f32 v[80:81], v[132:133], v[196:197], v[80:81]
  v_pk_fma_f32 v[82:83], v[134:135], v[198:199], v[82:83]
  v_pk_fma_f32 v[84:85], v[148:149], v[212:213], v[84:85]
  v_pk_fma_f32 v[86:87], v[150:151], v[214:215], v[86:87]
  v_cvt_pk_bf16_f32 v100, v72, v73
  v_cvt_pk_bf16_f32 v101, v74, v75
  v_cvt_pk_bf16_f32 v102, v76, v77
  v_cvt_pk_bf16_f32 v103, v78, v79
  ds_write_b64 v10, v[96:97] offset:0
  ds_write_b64 v10, v[98:99] offset:32
  v_lshlrev_b32 v48, 16, v112
  v_and_b32 v49, s33, v112
  v_lshlrev_b32 v50, 16, v113
  v_and_b32 v51, s33, v113
  v_lshlrev_b32 v52, 16, v114
  v_and_b32 v53, s33, v114
  v_lshlrev_b32 v54, 16, v115
  v_and_b32 v55, s33, v115
  v_pk_fma_f32 v[88:89], v[164:165], v[228:229], v[88:89]
  v_pk_fma_f32 v[90:91], v[166:167], v[230:231], v[90:91]
  v_pk_fma_f32 v[92:93], v[180:181], v[244:245], v[92:93]
  v_pk_fma_f32 v[94:95], v[182:183], v[246:247], v[94:95]
  v_cvt_pk_bf16_f32 v104, v80, v81
  v_cvt_pk_bf16_f32 v105, v82, v83
  v_cvt_pk_bf16_f32 v106, v84, v85
  v_cvt_pk_bf16_f32 v107, v86, v87
  ds_write_b64 v10, v[100:101] offset:64
  ds_write_b64 v10, v[102:103] offset:96
  s_waitcnt lgkmcnt(0)
  s_barrier
  v_lshlrev_b32 v56, 16, v116
  v_and_b32 v57, s33, v116
  v_lshlrev_b32 v58, 16, v117
  v_and_b32 v59, s33, v117
  v_lshlrev_b32 v60, 16, v118
  v_and_b32 v61, s33, v118
  v_lshlrev_b32 v62, 16, v119
  v_and_b32 v63, s33, v119
  v_pk_fma_f32 v[48:49], v[136:137], v[200:201], v[48:49]
  v_pk_fma_f32 v[50:51], v[138:139], v[202:203], v[50:51]
  v_pk_fma_f32 v[52:53], v[152:153], v[216:217], v[52:53]
  v_pk_fma_f32 v[54:55], v[154:155], v[218:219], v[54:55]
  v_cvt_pk_bf16_f32 v108, v88, v89
  v_cvt_pk_bf16_f32 v109, v90, v91
  v_cvt_pk_bf16_f32 v110, v92, v93
  v_cvt_pk_bf16_f32 v111, v94, v95
  ds_write_b64 v10, v[104:105] offset:4352
  ds_write_b64 v10, v[106:107] offset:4384
  v_lshlrev_b32 v64, 16, v120
  v_and_b32 v65, s33, v120
  v_lshlrev_b32 v66, 16, v121
  v_and_b32 v67, s33, v121
  v_lshlrev_b32 v68, 16, v122
  v_and_b32 v69, s33, v122
  v_lshlrev_b32 v70, 16, v123
  v_and_b32 v71, s33, v123
  v_pk_fma_f32 v[56:57], v[168:169], v[232:233], v[56:57]
  v_pk_fma_f32 v[58:59], v[170:171], v[234:235], v[58:59]
  v_pk_fma_f32 v[60:61], v[184:185], v[248:249], v[60:61]
  v_pk_fma_f32 v[62:63], v[186:187], v[250:251], v[62:63]
  v_cvt_pk_bf16_f32 v112, v48, v49
  v_cvt_pk_bf16_f32 v113, v50, v51
  v_cvt_pk_bf16_f32 v114, v52, v53
  v_cvt_pk_bf16_f32 v115, v54, v55
  ds_write_b64 v10, v[108:109] offset:4416
  ds_write_b64 v10, v[110:111] offset:4448
  s_waitcnt lgkmcnt(0)
  s_barrier
  v_lshlrev_b32 v72, 16, v124
  v_and_b32 v73, s33, v124
  v_lshlrev_b32 v74, 16, v125
  v_and_b32 v75, s33, v125
  v_lshlrev_b32 v76, 16, v126
  v_and_b32 v77, s33, v126
  v_lshlrev_b32 v78, 16, v127
  v_and_b32 v79, s33, v127
  v_pk_fma_f32 v[64:65], v[140:141], v[204:205], v[64:65]
  v_pk_fma_f32 v[66:67], v[142:143], v[206:207], v[66:67]
  v_pk_fma_f32 v[68:69], v[156:157], v[220:221], v[68:69]
  v_pk_fma_f32 v[70:71], v[158:159], v[222:223], v[70:71]
  v_cvt_pk_bf16_f32 v116, v56, v57
  v_cvt_pk_bf16_f32 v117, v58, v59
  v_cvt_pk_bf16_f32 v118, v60, v61
  v_cvt_pk_bf16_f32 v119, v62, v63
  ds_write_b64 v10, v[112:113] offset:8704
  ds_write_b64 v10, v[114:115] offset:8736
  v_pk_fma_f32 v[72:73], v[172:173], v[236:237], v[72:73]
  v_pk_fma_f32 v[74:75], v[174:175], v[238:239], v[74:75]
  v_pk_fma_f32 v[76:77], v[188:189], v[252:253], v[76:77]
  v_pk_fma_f32 v[78:79], v[190:191], v[254:255], v[78:79]
  v_cvt_pk_bf16_f32 v120, v64, v65
  v_cvt_pk_bf16_f32 v121, v66, v67
  v_cvt_pk_bf16_f32 v122, v68, v69
  v_cvt_pk_bf16_f32 v123, v70, v71
  ds_write_b64 v10, v[116:117] offset:8768
  ds_write_b64 v10, v[118:119] offset:8800
  s_waitcnt lgkmcnt(0)
  s_barrier
  v_cvt_pk_bf16_f32 v124, v72, v73
  v_cvt_pk_bf16_f32 v125, v74, v75
  v_cvt_pk_bf16_f32 v126, v76, v77
  v_cvt_pk_bf16_f32 v127, v78, v79
  ds_write_b64 v10, v[120:121] offset:13056
  ds_write_b64 v10, v[122:123] offset:13088
  ds_write_b64 v10, v[124:125] offset:13120
  ds_write_b64 v10, v[126:127] offset:13152
  s_waitcnt lgkmcnt(0)
  s_barrier
L_out:
  s_and_b32 s43, s3, 3
  s_lshl_b32 s43, s43, 2
  s_lshr_b32 s42, s3, 2
  s_lshl_b32 s42, s42, 6
  s_add_u32 s42, s42, s43
  s_add_u32 s42, s42, 48
  v_lshrrev_b32 v13, 4, v0
  v_add_u32 v13, s42, v13
  v_and_b32 v14, 15, v0
  v_mul_u32_u24 v15, 272, v13
  v_lshl_add_u32 v15, v14, 4, v15
  v_add_u32 v15, 98304, v15
  s_lshl_b32 s42, s16, 7
  v_add_u32 v13, s42, v13
  v_lshlrev_b32 v13, 11, v13
  v_lshl_add_u32 v13, v14, 4, v13
  s_lshl_b32 s42, s18, 8
  v_add_u32 v13, s42, v13
  s_mov_b32 s24, s10
  s_mov_b32 s25, s11
  s_mov_b32 s26, 0x800000
  s_mov_b32 s27, 0x20000
  ds_read_b128 v[32:35], v15 offset:0
  s_waitcnt lgkmcnt(0)
  buffer_store_dwordx4 v[32:35], v13, s[24:27], 0 offen sc1
L_end:
  s_endpgm
.section .rodata,"a"
.p2align 6
.amdhsa_kernel standalone__cross_network_dcn__recsys_kernel
  .amdhsa_next_free_vgpr 256
  .amdhsa_next_free_sgpr 96
  .amdhsa_accum_offset 256
  .amdhsa_group_segment_fixed_size 0
  .amdhsa_kernarg_size 48
  .amdhsa_user_sgpr_count 2
  .amdhsa_user_sgpr_kernarg_segment_ptr 1
  .amdhsa_system_sgpr_workgroup_id_x 1
.end_amdhsa_kernel
.text
```
